```python
import torch

def _softmax(x, axis=-1):
    return torch.softmax(x, dim=axis)
def _gelu(x):
    return torch.nn.functional.gelu(x, approximate="tanh")
def _silu(x):
    return torch.nn.functional.silu(x)
def _sigmoid(x):
    return torch.sigmoid(x)
def _layernorm(x, axis=-1, eps=1e-5):
    m = x.mean(dim=axis, keepdim=True)
    v = x.var(dim=axis, keepdim=True, unbiased=False)
    return (x - m) / torch.sqrt(v + eps)
def _scatter_add(tgt, idx, src, axis=0):
    return tgt.clone().index_add_(axis, idx, src)
def _segment_sum(src, seg, n):
    out = torch.zeros((n,) + src.shape[1:], dtype=src.dtype)
    return out.index_add_(0, seg, src)
def _pad(x, pw):
    flat = tuple(v for pair in reversed(pw) for v in pair)
    return torch.nn.functional.pad(x, flat)

kernel_name = 'parallel_sum__compressed_kv_cla__dense_activation_silu__decode'

def setup_inputs():

    _w = (lambda a: (lambda t: t.to(torch.bfloat16) if t.is_floating_point() else t)(torch.as_tensor(a)))
    def _A_setup():
        B, H, Sq, Sk, D, M = 2, 32, 1, 4096, 128, 512
        Dc = 4 * D
        return {
            "x": _w((lambda *s: torch.randn(*s, dtype=torch.bfloat16) * 0.05)(B, Sq, M)),
            "c_kv": _w((lambda *s: torch.randn(*s, dtype=torch.bfloat16) * 0.8)(B, Sk, Dc)),
            "w_q": _w((lambda *s: torch.randn(*s, dtype=torch.bfloat16) * 3.2)(M, H, D) * (M ** -0.5)),
            "w_uk": _w((lambda *s: torch.randn(*s, dtype=torch.bfloat16) * 3.2)(Dc, H, D) * (Dc ** -0.5)),
            "w_uv": _w((lambda *s: torch.randn(*s, dtype=torch.bfloat16) * 0.8)(Dc, H, D) * (Dc ** -0.5)),
            "w_o": _w((lambda *s: torch.randn(*s, dtype=torch.bfloat16) * 0.8)(H, D, M) * ((H * D) ** -0.5)),
        }
    _A_in = _A_setup()

    def _B_setup():
        B, S, D, F = 2, 1, 512, 1376
        return {
            "x": _w((lambda *s: torch.randn(*s, dtype=torch.bfloat16) * 0.05)(B, S, D)),
            "w1": _w((lambda *s: torch.randn(*s, dtype=torch.bfloat16) * 3.2)(D, F) * (D ** -0.5)),
            "w2": _w((lambda *s: torch.randn(*s, dtype=torch.bfloat16) * 0.2)(F, D) * (F ** -0.5)),
        }
    _B_in = _B_setup()

    return {
        "A_x": _A_in["x"],
        "A_c_kv": _A_in["c_kv"],
        "A_w_q": _A_in["w_q"],
        "A_w_uk": _A_in["w_uk"],
        "A_w_uv": _A_in["w_uv"],
        "A_w_o": _A_in["w_o"],
        "B_x": _B_in["x"],
        "B_w1": _B_in["w1"],
        "B_w2": _B_in["w2"],
    }

def reference(A_x, A_c_kv, A_w_q, A_w_uk, A_w_uv, A_w_o, B_x, B_w1, B_w2):
    def _A_ref(x, c_kv, w_q, w_uk, w_uv, w_o):
        B, Sq, M = x.shape[0], x.shape[1], x.shape[2]
        Sk = c_kv.shape[1]
        H, D = w_q.shape[1], w_q.shape[2]
        q = torch.einsum("bqm,mhd->bhqd", x, w_q)
        k = torch.einsum("bkc,chd->bhkd", c_kv, w_uk)
        v = torch.einsum("bkc,chd->bhkd", c_kv, w_uv)
        scores = torch.einsum("bhqd,bhkd->bhqk", q, k) * (D ** -0.5)
        off = Sk - Sq
        qi = torch.arange(Sq)[:, None]
        kj = torch.arange(Sk)[None, :]
        cmask = kj <= (qi + off)
        scores = torch.where(cmask[None, None], scores, -1e9)
        p = _softmax(scores, axis=-1)
        ctx = torch.einsum("bhqk,bhkd->bhqd", p, v)
        return torch.einsum("bhqd,hdm->bqm", ctx, w_o)

    def _B_ref(x, w1, w2):
        h = torch.einsum("bsd,df->bsf", x, w1)
        h = _silu(h)
        out = torch.einsum("bsf,fd->bsd", h, w2)
        return out

    x = A_x
    xn = _layernorm(x, axis=-1)
    return x + _A_ref(xn, A_c_kv, A_w_q, A_w_uk, A_w_uv, A_w_o) + _B_ref(xn, B_w1, B_w2)
```

```asm
; @launch grid=(256,1,1) block=(512,1,1) lds=154880
.amdgcn_target "amdgcn-amd-amdhsa--gfx950"
.text
.globl parallel_sum__compressed_kv_cla__dense_activation_silu__decode_kernel
.p2align 8
.type parallel_sum__compressed_kv_cla__dense_activation_silu__decode_kernel,@function
parallel_sum__compressed_kv_cla__dense_activation_silu__decode_kernel:
  s_load_dwordx2 s[16:17], s[0:1], 16
  s_load_dwordx2 s[8:9], s[0:1], 0
  s_getpc_b64 s[46:47]
L_pc:
  v_lshlrev_b32 v5, 7, v0
  s_cmpk_ge_u32 s2, 0x100
  s_cbranch_scc1 L_end
  v_min_u32 v5, L_codeend-L_pc-4, v5
  v_lshrrev_b32 v4, 6, v0
  global_load_dword v252, v5, s[46:47]
  v_readfirstlane_b32 s5, v4
  s_lshr_b32 s4, s2, 3
  s_and_b32 s3, s2, 7
  v_and_b32 v2, 15, v0
  v_bfe_u32 v3, v0, 4, 2
  s_cmp_ge_u32 s4, 16
  s_cbranch_scc1 L_A
  s_lshr_b32 s45, s4, 2
  s_lshl2_add_u32 s6, s3, s45
  s_and_b32 s7, s4, 3
  s_and_b32 s58, s5, 3
  s_lshl2_add_u32 s45, s7, s58
  s_lshl_b32 s45, s45, 18
  s_lshl_b32 s57, s6, 8
  s_add_u32 s57, s57, s45
  s_lshl_b32 s58, s58, 13
  v_lshlrev_b32 v4, 1, v3
  v_xor_b32 v4, v2, v4
  v_lshlrev_b32 v4, 4, v4
  v_lshl_add_u32 v10, v3, 13, v4
  v_lshlrev_b32 v5, 25, v0
  v_lshrrev_b32 v5, 21, v5
  s_lshl_b32 s18, 1, 22
  s_lshl_b32 s19, 1, 17
  s_mov_b32 m0, s58
  s_movk_i32 s48, 0x80
  s_lshl_b32 s49, 1, 15
  s_mov_b32 s47, 3
  s_cmp_gt_u32 s5, 3
  s_waitcnt lgkmcnt(0)
  global_load_dwordx4 v[20:23], v5, s[8:9]
  s_cbranch_scc1 L_w_hi
L_wq:
  buffer_load_dwordx4 v10, s[16:19], s57 offen  lds
  s_addk_i32 m0, 0x400
  s_add_u32 s57, s57, s49
  buffer_load_dwordx4 v10, s[16:19], s57 offen  lds
  s_addk_i32 m0, 0x400
  s_add_u32 s57, s57, s49
  v_xor_b32 v10, s48, v10
  s_sub_u32 s47, s47, 1
  s_cbranch_scc0 L_wq
  s_sub_u32 s57, s57, 262144
L_w_hi:
  s_load_dwordx2 s[12:13], s[0:1], 88
  s_load_dwordx2 s[20:21], s[0:1], 24
  s_load_dwordx2 s[24:25], s[0:1], 32
  s_load_dwordx2 s[32:33], s[0:1], 56
  s_load_dwordx2 s[40:41], s[0:1], 8
  s_mov_b32 s14, 268435456
  s_mov_b32 s15, 0x00020000
  s_mov_b32 s22, 4194304
  s_mov_b32 s23, 0x00020000
  v_and_b32 v1, 63, v0
  v_mov_b32 v7, 0
  v_lshlrev_b32 v8, 4, v1
  v_xor_b32 v4, v2, v3
  v_lshlrev_b32 v4, 4, v4
  v_lshl_add_u32 v12, v3, 13, v4
  v_xor_b32 v13, 0x40, v12
  v_xor_b32 v14, 0x80, v12
  v_xor_b32 v15, 0xc0, v12
  s_lshl_b32 s59, s3, 4
  s_add_u32 s59, s59, s4
  v_lshlrev_b32 v9, 15, v3
  v_lshl_add_u32 v9, v2, 4, v9
  s_lshl_b32 s60, s59, 8
  s_add_u32 s60, s60, 327680
  s_lshl_b32 s62, s59, 10
  s_add_u32 s45, s62, 65536
  v_lshlrev_b32 v28, 7, v1
  v_mov_b32 v24, -1
  v_mov_b32 v25, -1
  v_mov_b32 v26, -1
  v_mov_b32 v27, -1
  s_waitcnt lgkmcnt(0)
  s_load_dword s44, s[12:13], 0
  s_cmp_lg_u32 s5, 0
  s_cbranch_scc1 L_w_norst
  s_mov_b64 exec, 0xff
  buffer_load_dword v29, v28, s[12:15], s45 offen sc1
  s_mov_b32 exec_lo, -1
  buffer_store_dwordx4 v[24:27], v9, s[12:15], s60 offen sc1
  s_mov_b64 exec, -1
L_w_norst:
  s_cmp_lt_u32 s5, 4
  s_cbranch_scc1 L_w_lo
  s_add_u32 m0, s58, 38912
  s_add_u32 s45, s57, 0
  buffer_load_dwordx4 v12, s[20:23], s45 offen  lds
  s_add_u32 m0, s58, 39936
  s_add_u32 s45, s57, 32768
  buffer_load_dwordx4 v13, s[20:23], s45 offen  lds
  s_add_u32 m0, s58, 40960
  s_add_u32 s45, s57, 65536
  buffer_load_dwordx4 v14, s[20:23], s45 offen  lds
  s_add_u32 m0, s58, 41984
  s_add_u32 s45, s57, 98304
  buffer_load_dwordx4 v15, s[20:23], s45 offen  lds
  s_add_u32 m0, s58, 43008
  s_add_u32 s45, s57, 131072
  buffer_load_dwordx4 v12, s[20:23], s45 offen  lds
  s_add_u32 m0, s58, 44032
  s_add_u32 s45, s57, 163840
  buffer_load_dwordx4 v13, s[20:23], s45 offen  lds
  s_add_u32 m0, s58, 45056
  s_add_u32 s45, s57, 196608
  buffer_load_dwordx4 v14, s[20:23], s45 offen  lds
  s_add_u32 m0, s58, 46080
  s_add_u32 s45, s57, 229376
  buffer_load_dwordx4 v15, s[20:23], s45 offen  lds
L_w_lo:
  s_mov_b32 s26, 4194304
  s_mov_b32 s27, 0x00020000
  s_mov_b32 s34, 1409024
  s_mov_b32 s35, 0x00020000
  s_mov_b32 s50, 0x07060501
  s_mov_b32 s51, 0x07060502
  s_mov_b32 s52, 0x07060503
  s_mov_b32 s53, 0x0c04000c
  s_mov_b32 s54, 0x00030003
  s_mov_b32 s55, 0x00030003
  s_mov_b32 s42, 8388608
  s_mov_b32 s43, 0x00020000
  s_lshl_b32 s99, s3, 20
  s_lshr_b32 s45, s4, 1
  s_lshl_b32 s45, s45, 17
  s_add_u32 s99, s99, s45
  s_and_b32 s45, s4, 1
  s_lshl_b32 s45, s45, 15
  s_add_u32 s99, s99, s45
  s_add_u32 s99, s99, s58
  s_add_u32 s99, s99, 0x10000
  v_lshrrev_b32 v4, 2, v2
  v_and_b32 v5, 3, v2
  v_and_b32 v30, 1, v3
  v_lshl_or_b32 v30, v30, 2, v4
  v_xor_b32 v30, s5, v30
  v_lshlrev_b32 v30, 5, v30
  v_lshl_add_u32 v30, v5, 3, v30
  v_lshl_add_u32 v31, v3, 3, v4
  v_lshl_add_u32 v16, v31, 8, v30
  v_and_b32 v32, 1, v2
  v_mul_u32_u24 v17, 1088, v32
  s_lshl_b32 s45, s7, 8
  v_lshl_add_u32 v18, v3, 4, v17
  v_add_u32 v18, s45, v18
  v_mul_u32_u24 v19, 320, v32
  v_lshl_add_u32 v33, v3, 4, v19
  v_lshlrev_b32 v34, 5, v3
  v_lshl_add_u32 v34, v2, 4, v34
  v_lshrrev_b32 v36, 1, v1
  v_lshl_add_u32 v37, v36, 3, v19
  v_xor_b32 v40, v2, v3
  v_lshlrev_b32 v40, 4, v40
  v_lshl_add_u32 v40, v2, 8, v40
  s_lshl_b32 s45, s5, 12
  v_add_u32 v40, s45, v40
  v_xor_b32 v41, 0x40, v40
  v_xor_b32 v42, 0x80, v40
  v_xor_b32 v43, 0xc0, v40
  s_lshl_b32 s45, s5, 5
  v_lshl_add_u32 v39, v3, 3, s45
  v_lshl_add_u32 v44, v2, 8, v39
  v_add_u32 v45, v19, v39
  s_lshl_b32 s45, s5, 7
  s_add_u32 s62, s62, s45
  s_lshl_b32 s61, s6, 12
  s_add_u32 s63, s61, 196608
  s_add_u32 s61, s61, 65536
  s_add_u32 s48, s62, 65536
  s_add_u32 s49, s62, 196608
  s_cmp_gt_u32 s5, 3
  s_cbranch_scc1 L_w_lnend
  s_cmp_lg_u32 s5, 1
  s_cbranch_scc1 L_w_noinit
  v_lshlrev_b32 v46, 2, v1
  ds_write_b32 v46, v7 offset:38016
  ds_write_b32 v46, v7 offset:38272
L_w_noinit:
  s_cmp_lt_u32 s5, 2
  s_cbranch_scc1 L_w_noln
  s_waitcnt vmcnt(8)
  v_lshlrev_b32 v48, 16, v20
  v_and_b32 v49, 0xffff0000, v20
  v_lshlrev_b32 v50, 16, v21
  v_and_b32 v51, 0xffff0000, v21
  v_lshlrev_b32 v52, 16, v22
  v_and_b32 v53, 0xffff0000, v22
  v_lshlrev_b32 v54, 16, v23
  v_and_b32 v55, 0xffff0000, v23
  v_add_f32 v56, v48, v49
  v_add_f32 v57, v50, v51
  v_add_f32 v58, v52, v53
  v_add_f32 v59, v54, v55
  v_add_f32 v56, v56, v57
  v_add_f32 v58, v58, v59
  v_add_f32 v56, v56, v58
  s_nop 1
  v_add_f32_dpp v56, v56, v56 quad_perm:[1,0,3,2] row_mask:0xf bank_mask:0xf
  s_nop 1
  v_add_f32_dpp v56, v56, v56 quad_perm:[2,3,0,1] row_mask:0xf bank_mask:0xf
  s_nop 1
  v_add_f32_dpp v56, v56, v56 row_half_mirror row_mask:0xf bank_mask:0xf
  s_nop 1
  v_add_f32_dpp v56, v56, v56 row_mirror row_mask:0xf bank_mask:0xf
  v_mov_b32 v57, v56
  s_nop 1
  v_permlane16_swap_b32 v56, v57
  s_nop 0
  v_add_f32 v56, v56, v57
  v_mov_b32 v57, v56
  s_nop 1
  v_permlane32_swap_b32 v56, v57
  s_nop 0
  v_add_f32 v56, v56, v57
  v_mul_f32 v56, 0x3b000000, v56
  v_sub_f32 v60, v48, v56
  v_sub_f32 v61, v49, v56
  v_sub_f32 v62, v50, v56
  v_sub_f32 v63, v51, v56
  v_sub_f32 v64, v52, v56
  v_sub_f32 v65, v53, v56
  v_sub_f32 v66, v54, v56
  v_sub_f32 v67, v55, v56
  v_mul_f32 v57, v60, v60
  v_fmac_f32 v57, v61, v61
  v_fmac_f32 v57, v62, v62
  v_fmac_f32 v57, v63, v63
  v_fmac_f32 v57, v64, v64
  v_fmac_f32 v57, v65, v65
  v_fmac_f32 v57, v66, v66
  v_fmac_f32 v57, v67, v67
  s_nop 1
  v_add_f32_dpp v57, v57, v57 quad_perm:[1,0,3,2] row_mask:0xf bank_mask:0xf
  s_nop 1
  v_add_f32_dpp v57, v57, v57 quad_perm:[2,3,0,1] row_mask:0xf bank_mask:0xf
  s_nop 1
  v_add_f32_dpp v57, v57, v57 row_half_mirror row_mask:0xf bank_mask:0xf
  s_nop 1
  v_add_f32_dpp v57, v57, v57 row_mirror row_mask:0xf bank_mask:0xf
  v_mov_b32 v58, v57
  s_nop 1
  v_permlane16_swap_b32 v57, v58
  s_nop 0
  v_add_f32 v57, v57, v58
  v_mov_b32 v58, v57
  s_nop 1
  v_permlane32_swap_b32 v57, v58
  s_nop 0
  v_add_f32 v57, v57, v58
  v_mul_f32 v57, 0x3b000000, v57
  v_cvt_pk_bf16_f32 v56, v56, v56
  v_lshlrev_b32 v56, 16, v56
  v_cvt_pk_bf16_f32 v57, v57, v57
  v_lshlrev_b32 v57, 16, v57
  v_add_f32 v57, 0x3727c5ac, v57
  v_cvt_pk_bf16_f32 v57, v57, v57
  v_lshlrev_b32 v57, 16, v57
  v_sqrt_f32 v57, v57
  s_nop 0
  v_cvt_pk_bf16_f32 v57, v57, v57
  v_lshlrev_b32 v57, 16, v57
  v_rcp_f32 v57, v57
  v_sub_f32 v60, v48, v56
  v_sub_f32 v61, v49, v56
  v_sub_f32 v62, v50, v56
  v_sub_f32 v63, v51, v56
  v_sub_f32 v64, v52, v56
  v_sub_f32 v65, v53, v56
  v_sub_f32 v66, v54, v56
  v_sub_f32 v67, v55, v56
  v_cvt_pk_bf16_f32 v48, v60, v61
  v_cvt_pk_bf16_f32 v49, v62, v63
  v_cvt_pk_bf16_f32 v50, v64, v65
  v_cvt_pk_bf16_f32 v51, v66, v67
  v_lshlrev_b32 v60, 16, v48
  v_and_b32 v61, 0xffff0000, v48
  v_lshlrev_b32 v62, 16, v49
  v_and_b32 v63, 0xffff0000, v49
  v_lshlrev_b32 v64, 16, v50
  v_and_b32 v65, 0xffff0000, v50
  v_lshlrev_b32 v66, 16, v51
  v_and_b32 v67, 0xffff0000, v51
  v_mul_f32 v60, v60, v57
  v_mul_f32 v61, v61, v57
  v_mul_f32 v62, v62, v57
  v_mul_f32 v63, v63, v57
  v_mul_f32 v64, v64, v57
  v_mul_f32 v65, v65, v57
  v_mul_f32 v66, v66, v57
  v_mul_f32 v67, v67, v57
  v_cvt_pk_bf16_f32 v48, v60, v61
  v_cvt_pk_bf16_f32 v49, v62, v63
  v_cvt_pk_bf16_f32 v50, v64, v65
  v_cvt_pk_bf16_f32 v51, v66, v67
  s_and_b32 s45, s5, 1
  s_mul_i32 s45, s45, 1088
  v_add_u32 v56, s45, v8
  ds_write_b128 v56, v[48:51] offset:32768
L_w_noln:
  s_cmp_eq_u32 s5, 0
  s_cbranch_scc1 L_w_w0
  s_waitcnt vmcnt(0)
L_w_w0:
  s_waitcnt vmcnt(2)
L_w_lnend:
  s_waitcnt lgkmcnt(0)
  s_add_u32 s44, s44, 1
  s_barrier
  ds_read_b128 v[56:59], v18 offset:32768
  ds_read_b64_tr_b16 v[72:73], v16 offset:0
  ds_read_b64_tr_b16 v[74:75], v16 offset:1024
  ds_read_b128 v[60:63], v18 offset:32832
  ds_read_b64_tr_b16 v[76:77], v16 offset:8192
  ds_read_b64_tr_b16 v[78:79], v16 offset:9216
  ds_read_b128 v[64:67], v18 offset:32896
  ds_read_b64_tr_b16 v[80:81], v16 offset:16384
  ds_read_b64_tr_b16 v[82:83], v16 offset:17408
  ds_read_b128 v[68:71], v18 offset:32960
  ds_read_b64_tr_b16 v[84:85], v16 offset:24576
  ds_read_b64_tr_b16 v[86:87], v16 offset:25600
  s_waitcnt lgkmcnt(9)
  v_mfma_f32_16x16x32_bf16 v[88:91], v[72:75], v[56:59], 0
  s_waitcnt lgkmcnt(6)
  v_mfma_f32_16x16x32_bf16 v[88:91], v[76:79], v[60:63], v[88:91]
  s_waitcnt lgkmcnt(3)
  v_mfma_f32_16x16x32_bf16 v[88:91], v[80:83], v[64:67], v[88:91]
  s_waitcnt lgkmcnt(0)
  v_mfma_f32_16x16x32_bf16 v[88:91], v[84:87], v[68:71], v[88:91]
  s_nop 7
  v_perm_b32 v92, v88, v91, s50
  v_perm_b32 v93, v89, v91, s51
  v_perm_b32 v94, v90, v91, s52
  v_mov_b32 v95, s44
  s_mov_b64 exec, s[54:55]
  buffer_store_dwordx4 v[92:95], v34, s[12:15], s48 offen
  s_cmp_gt_u32 s5, 3
  s_cbranch_scc1 L_w_h0
  buffer_store_dwordx4 v[92:95], v34, s[12:15], s49 offen sc1
  s_cmp_lg_u32 s5, 0
  s_cbranch_scc1 L_w_h0done
  s_lshl_b32 s45, s59, 7
  s_add_u32 s45, s45, 16384
  v_mov_b32 v6, s44
  s_mov_b64 exec, 1
  s_waitcnt vmcnt(2)
  buffer_store_dword v6, v7, s[12:15], s45 offen sc1
  s_branch L_w_h0done
L_w_h0:
  s_mov_b64 exec, -1
  s_cmp_eq_u32 s5, 7
  s_cbranch_scc1 L_w_h0p
  s_mov_b64 exec, s[54:55]
  buffer_store_dwordx4 v[92:95], v34, s[12:15], s49 offen sc1
  s_waitcnt vmcnt(2)
  s_branch L_w_h0done
L_w_h0p:
  s_waitcnt vmcnt(1)
  s_mov_b32 s56, 0
  s_mov_b32 s45, s61
L_h0_ld:
  buffer_load_dwordx4 v[96:99], v8, s[12:15], s45 offen offset:0 sc1
  buffer_load_dwordx4 v[100:103], v8, s[12:15], s45 offen offset:1024 sc1
  buffer_load_dwordx4 v[104:107], v8, s[12:15], s45 offen offset:2048 sc1
  buffer_load_dwordx4 v[108:111], v8, s[12:15], s45 offen offset:3072 sc1
  s_add_u32 s56, s56, 1
  s_cmp_lg_u32 s56, 6
  s_cbranch_scc1 L_h0_nb
  s_mov_b64 exec, s[54:55]
  buffer_store_dwordx4 v[92:95], v34, s[12:15], s49 offen sc1
  s_mov_b64 exec, -1
L_h0_nb:
  s_cmp_gt_u32 s56, 16
  s_cselect_b32 s45, s56, 0
  s_and_b32 s45, s45, 3
  s_cmp_eq_u32 s45, 3
  s_cselect_b32 s45, s63, s61
  s_waitcnt vmcnt(0)
  v_xor_b32 v112, s44, v99
  v_xor_b32 v113, s44, v103
  v_xor_b32 v114, s44, v107
  v_xor_b32 v115, s44, v111
  v_or3_b32 v112, v112, v113, v114
  v_or_b32 v112, v112, v115
  v_cmp_ne_u32 vcc, 0, v112
  s_cbranch_vccz L_h0_ok
  s_cmp_lt_u32 s56, 262144
  s_cbranch_scc1 L_h0_ld
L_h0_ok:
  s_cmp_ge_u32 s56, 6
  s_cbranch_scc1 L_h0_bdone
  s_mov_b64 exec, s[54:55]
  buffer_store_dwordx4 v[92:95], v34, s[12:15], s49 offen sc1
  s_mov_b64 exec, -1
L_h0_bdone:
  v_perm_b32 v99, v97, v96, s53
  v_lshl_or_b32 v99, v98, 24, v99
  v_perm_b32 v103, v101, v100, s53
  v_lshl_or_b32 v103, v102, 24, v103
  v_perm_b32 v107, v105, v104, s53
  v_lshl_or_b32 v107, v106, 24, v107
  v_perm_b32 v111, v109, v108, s53
  v_lshl_or_b32 v111, v110, 24, v111
  v_add_f32 v96, v96, v100
  v_add_f32 v104, v104, v108
  v_add_f32 v97, v97, v101
  v_add_f32 v105, v105, v109
  v_add_f32 v98, v98, v102
  v_add_f32 v106, v106, v110
  v_add_f32 v99, v99, v103
  v_add_f32 v107, v107, v111
  v_add_f32 v96, v96, v104
  v_add_f32 v97, v97, v105
  v_add_f32 v98, v98, v106
  v_add_f32 v99, v99, v107
  v_cvt_pk_bf16_f32 v96, v96, v97
  v_cvt_pk_bf16_f32 v97, v98, v99
  ds_write_b64 v37, v[96:97] offset:35072
L_w_h0done:
  s_mov_b64 exec, -1
  s_waitcnt lgkmcnt(0)
  s_barrier
  ds_read_b128 v[56:59], v33 offset:35072
  ds_read_b128 v[72:75], v40 offset:38912
  ds_read_b128 v[60:63], v33 offset:35136
  ds_read_b128 v[76:79], v41 offset:38912
  ds_read_b128 v[64:67], v33 offset:35200
  ds_read_b128 v[80:83], v42 offset:38912
  ds_read_b128 v[68:71], v33 offset:35264
  ds_read_b128 v[84:87], v43 offset:38912
  s_waitcnt lgkmcnt(6)
  v_mfma_f32_16x16x32_bf16 v[88:91], v[72:75], v[56:59], 0
  s_waitcnt lgkmcnt(4)
  v_mfma_f32_16x16x32_bf16 v[88:91], v[76:79], v[60:63], v[88:91]
  s_waitcnt lgkmcnt(2)
  v_mfma_f32_16x16x32_bf16 v[88:91], v[80:83], v[64:67], v[88:91]
  s_waitcnt lgkmcnt(0)
  v_mfma_f32_16x16x32_bf16 v[88:91], v[84:87], v[68:71], v[88:91]
  s_nop 7
  v_cvt_pk_bf16_f32 v92, v88, v89
  v_cvt_pk_bf16_f32 v93, v90, v91
  s_mov_b64 exec, s[54:55]
  ds_write_b64 v44, v[92:93] offset:35712
  s_mov_b64 exec, -1
  s_waitcnt lgkmcnt(0)
  s_barrier
  s_cmp_lg_u32 s5, 0
  s_cbranch_scc1 L_w_noqa
  s_mov_b32 exec_hi, 0
  ds_read_b128 v[92:95], v8 offset:35712
  s_waitcnt lgkmcnt(0)
  buffer_store_dwordx4 v[92:95], v9, s[12:15], s60 offen sc1
  s_mov_b64 exec, -1
  s_sub_u32 s99, s99, s58
  buffer_load_dword v29, v28, s[40:43], s99 offen
  s_add_u32 s99, s99, 8192
  buffer_load_dword v29, v28, s[40:43], s99 offen
  s_add_u32 s99, s99, 8192
  buffer_load_dword v29, v28, s[40:43], s99 offen
  s_add_u32 s99, s99, 8192
  buffer_load_dword v29, v28, s[40:43], s99 offen
L_w_noqa:
  s_lshl_b32 s98, s59, 11
  s_add_u32 s98, s98, 786432
  s_waitcnt vmcnt(0)
  s_barrier
  s_cmp_gt_u32 s5, 3
  s_cbranch_scc1 L_w_s2hi
  v_xor_b32 v11, 0x80, v10
  s_add_u32 m0, s58, 0
  s_add_u32 s45, s57, 0
  buffer_load_dwordx4 v10, s[24:27], s45 offen  lds
  s_add_u32 m0, s58, 1024
  s_add_u32 s45, s57, 32768
  buffer_load_dwordx4 v10, s[24:27], s45 offen  lds
  s_add_u32 m0, s58, 2048
  s_add_u32 s45, s57, 65536
  buffer_load_dwordx4 v11, s[24:27], s45 offen  lds
  s_add_u32 m0, s58, 3072
  s_add_u32 s45, s57, 98304
  buffer_load_dwordx4 v11, s[24:27], s45 offen  lds
  s_add_u32 m0, s58, 4096
  s_add_u32 s45, s57, 131072
  buffer_load_dwordx4 v10, s[24:27], s45 offen  lds
  s_add_u32 m0, s58, 5120
  s_add_u32 s45, s57, 163840
  buffer_load_dwordx4 v10, s[24:27], s45 offen  lds
  s_add_u32 m0, s58, 6144
  s_add_u32 s45, s57, 196608
  buffer_load_dwordx4 v11, s[24:27], s45 offen  lds
  s_add_u32 m0, s58, 7168
  s_add_u32 s45, s57, 229376
  buffer_load_dwordx4 v11, s[24:27], s45 offen  lds
  s_branch L_w_s2done
L_w_s2hi:
  s_cmp_lg_u32 s5, 6
  s_cbranch_scc1 L_w_nopre
  s_lshl_b32 s45, s59, 10
  s_add_u32 s45, s45, 458752
  s_mov_b64 exec, 0xff
  buffer_load_dword v29, v28, s[12:15], s45 offen sc1
  s_mov_b64 exec, 0xfff
  buffer_load_dword v29, v28, s[12:15], s98 offen sc1
  s_mov_b64 exec, -1
L_w_nopre:
  s_mul_i32 s46, s3, 11
  s_sub_u32 s45, s3, 6
  s_max_i32 s45, s45, 0
  s_sub_u32 s46, s46, s45
  s_mul_i32 s45, s4, 88064
  s_lshl_b32 s48, s46, 5
  s_add_u32 s45, s45, s48
  s_lshr_b32 s48, s58, 7
  v_add_u32 v46, s48, v1
  s_movk_i32 s47, 2400
  s_lshr_b32 s48, s58, 3
  v_mul_u32_u24 v47, 2979, v46
  v_lshrrev_b32 v47, 16, v47
  v_lshlrev_b32 v48, 4, v46
  v_mad_u32_u24 v47, v47, s47, v48
  s_add_u32 m0, s48, 83968
  v_add_u32 v46, 0x100, v46
  buffer_load_dwordx4 v47, s[32:35], s45 offen  lds
  v_mul_u32_u24 v47, 2979, v46
  v_lshrrev_b32 v47, 16, v47
  v_lshlrev_b32 v48, 4, v46
  v_mad_u32_u24 v47, v47, s47, v48
  s_add_u32 m0, s48, 88064
  v_add_u32 v46, 0x100, v46
  buffer_load_dwordx4 v47, s[32:35], s45 offen  lds
  s_cmp_eq_u32 s5, 7
  s_cbranch_scc1 L_w_w1done
  v_mul_u32_u24 v47, 2979, v46
  v_lshrrev_b32 v47, 16, v47
  v_lshlrev_b32 v48, 4, v46
  v_mad_u32_u24 v47, v47, s47, v48
  s_add_u32 m0, s48, 92160
  v_add_u32 v46, 0x100, v46
  buffer_load_dwordx4 v47, s[32:35], s45 offen  lds
L_w_w1done:
L_w_s2done:
  v_add_u32 v53, 100352, v16
  v_lshrrev_b32 v51, 3, v0
  v_and_b32 v50, 7, v0
  v_lshlrev_b32 v50, 4, v50
  v_lshl_add_u32 v50, v51, 8, v50
  v_add_u32 v50, 100352, v50
  v_lshlrev_b32 v51, 2, v51
  v_mul_u32_u24 v54, 192, v32
  v_lshl_add_u32 v54, v3, 4, v54
  v_lshlrev_b32 v55, 1, v3
  v_xor_b32 v55, v2, v55
  s_and_b32 s45, s5, 1
  s_lshl_b32 s45, s45, 3
  v_xor_b32 v55, s45, v55
  v_lshlrev_b32 v55, 4, v55
  v_lshl_add_u32 v55, v3, 8, v55
  s_lshl_b32 s101, s59, 14
  s_lshl_b32 s45, s5, 11
  s_add_u32 s101, s101, s45
  s_add_u32 s101, s101, 1048576
  s_add_u32 s57, s45, 100352
  v_lshl_add_u32 v64, v3, 2, v4
  v_mul_u32_u24 v64, 352, v64
  v_lshl_add_u32 v64, v5, 3, v64
  s_lshl_b32 s48, s5, 5
  s_add_u32 s48, s48, 83968
  v_add_u32 v64, s48, v64
  s_lshl_b32 s48, s4, 6
  v_lshl_add_u32 v65, v3, 3, v17
  v_add_u32 v65, s48, v65
  s_lshl_b32 s48, s5, 7
  s_add_u32 s48, s48, s98
  s_add_u32 s49, s48, 2359296
  s_cmp_lt_u32 s5, 4
  s_cbranch_scc1 L_w_w1in
  s_waitcnt vmcnt(0)
L_w_w1in:
  s_barrier
  ds_read_b64 v[56:57], v65 offset:32768
  ds_read_b64 v[58:59], v65 offset:32800
  ds_read_b64_tr_b16 v[72:73], v64 offset:0
  ds_read_b64_tr_b16 v[74:75], v64 offset:5632
  ds_read_b64_tr_b16 v[76:77], v64 offset:256
  ds_read_b64_tr_b16 v[78:79], v64 offset:5888
  s_waitcnt lgkmcnt(2)
  v_mfma_f32_16x16x32_bf16 v[88:91], v[72:75], v[56:59], 0
  s_waitcnt lgkmcnt(0)
  v_mfma_f32_16x16x32_bf16 v[84:87], v[76:79], v[56:59], 0
  s_nop 6
  v_perm_b32 v92, v88, v91, s50
  v_perm_b32 v93, v89, v91, s51
  v_perm_b32 v94, v90, v91, s52
  v_mov_b32 v95, s44
  s_mov_b64 exec, s[54:55]
  buffer_store_dwordx4 v[92:95], v34, s[12:15], s48 offen
  buffer_store_dwordx4 v[92:95], v34, s[12:15], s49 offen sc1
  s_cmp_gt_u32 s5, 2
  s_cbranch_scc1 L_w_ffn1done
  v_perm_b32 v80, v84, v87, s50
  v_perm_b32 v81, v85, v87, s51
  v_perm_b32 v82, v86, v87, s52
  v_mov_b32 v83, s44
  buffer_store_dwordx4 v[80:83], v34, s[12:15], s48 offen offset:1024
  buffer_store_dwordx4 v[80:83], v34, s[12:15], s49 offen offset:1024 sc1
L_w_ffn1done:
  s_mov_b64 exec, -1
  s_cmp_eq_u32 s5, 3
  s_cbranch_scc1 L_w_uv2
  s_waitcnt vmcnt(4)
  s_branch L_w_uvin
L_w_uv2:
  s_waitcnt vmcnt(2)
L_w_uvin:
  s_barrier
  ds_read_b64_tr_b16 v[96:97], v16 offset:0
  ds_read_b64_tr_b16 v[98:99], v16 offset:1024
  ds_read_b64_tr_b16 v[100:101], v16 offset:8192
  ds_read_b64_tr_b16 v[102:103], v16 offset:9216
  ds_read_b64_tr_b16 v[104:105], v16 offset:16384
  ds_read_b64_tr_b16 v[106:107], v16 offset:17408
  ds_read_b64_tr_b16 v[108:109], v16 offset:24576
  ds_read_b64_tr_b16 v[110:111], v16 offset:25600
  s_lshr_b32 s45, s6, 4
  s_lshl_b32 s45, s45, 16
  s_and_b32 s46, s3, 3
  s_lshl_b32 s46, s46, 8
  s_add_u32 s48, s45, s46
  s_lshl_b32 s46, s7, 6
  s_add_u32 s48, s48, s46
  s_and_b32 s46, s6, 3
  s_lshl_b32 s46, s46, 4
  s_add_u32 s48, s48, s46
  s_add_u32 s99, s48, 3407872
  v_lshlrev_b32 v62, 8, v51
  v_lshlrev_b32 v63, 1, v51
  v_mov_b32 v68, 1
  s_mov_b32 s58, 1
  s_mov_b32 m0, s57
  s_mov_b32 s56, 0
  buffer_load_dwordx4 v[56:59], v62, s[12:15], s99 offen sc1
  s_waitcnt vmcnt(0)
L_st_chk:
  v_cmp_ne_u32 vcc, s44, v59
  s_cbranch_vccz L_st_ok
  s_add_u32 s56, s56, 1
  s_cmp_gt_u32 s56, 262144
  s_cbranch_scc1 L_st_ok
  s_mov_b32 s45, s99
  buffer_load_dwordx4 v[56:59], v62, s[12:15], s45 offen sc1
  s_waitcnt vmcnt(0)
  s_branch L_st_chk
L_st_ok:
  buffer_load_dwordx4 v55, s[12:15], s101 offen sc1 lds
  buffer_load_dwordx4 v55, s[12:15], s101 offen offset:1024 sc1 lds
L_st_in:
  ds_write_b64 v63, v[56:57] offset:38528
  s_mov_b64 exec, 1
  ds_add_rtn_u32 v69, v7, v68 offset:38404
  s_mov_b64 exec, -1
  v_lshlrev_b32 v63, 3, v1
  ds_read_b64 v[64:65], v63 offset:38528
  s_waitcnt lgkmcnt(0)
  v_readfirstlane_b32 s45, v69
  s_nop 1
  s_cmp_lg_u32 s45, 7
  s_cbranch_scc1 L_w_owait
  v_mov_b32 v60, v64
  s_nop 1
  v_max_f32_dpp v60, v60, v60 quad_perm:[1,0,3,2] row_mask:0xf bank_mask:0xf
  s_nop 1
  v_max_f32_dpp v60, v60, v60 quad_perm:[2,3,0,1] row_mask:0xf bank_mask:0xf
  s_nop 1
  v_max_f32_dpp v60, v60, v60 row_half_mirror row_mask:0xf bank_mask:0xf
  s_nop 1
  v_max_f32_dpp v60, v60, v60 row_mirror row_mask:0xf bank_mask:0xf
  v_mov_b32 v61, v60
  s_nop 1
  v_permlane16_swap_b32 v60, v61
  s_nop 0
  v_max_f32 v60, v60, v61
  v_sub_f32 v60, v64, v60
  v_exp_f32 v60, v60
  s_nop 0
  v_mul_f32 v61, v60, v65
  s_nop 1
  v_add_f32_dpp v61, v61, v61 quad_perm:[1,0,3,2] row_mask:0xf bank_mask:0xf
  s_nop 1
  v_add_f32_dpp v61, v61, v61 quad_perm:[2,3,0,1] row_mask:0xf bank_mask:0xf
  s_nop 1
  v_add_f32_dpp v61, v61, v61 row_half_mirror row_mask:0xf bank_mask:0xf
  s_nop 1
  v_add_f32_dpp v61, v61, v61 row_mirror row_mask:0xf bank_mask:0xf
  v_mov_b32 v63, v61
  s_nop 1
  v_permlane16_swap_b32 v61, v63
  s_nop 0
  v_add_f32 v61, v61, v63
  v_rcp_f32 v61, v61
  v_lshrrev_b32 v63, 5, v1
  v_mul_u32_u24 v63, 192, v63
  v_mul_f32 v60, v60, v61
  v_lshl_add_u32 v63, v1, 1, v63
  v_cvt_pk_bf16_f32 v60, v60, v60
  ds_write_b16 v63, v60 offset:38016
  s_branch L_w_owait
L_w_oretry:
  s_add_u32 s58, s58, 1
  buffer_load_dwordx4 v55, s[12:15], s101 offen sc1 lds
  buffer_load_dwordx4 v55, s[12:15], s101 offen offset:1024 sc1 lds
L_w_owait:
  s_waitcnt vmcnt(0) lgkmcnt(0)
  s_barrier
  ds_read_b128 v[60:63], v54 offset:38016
  ds_read_b64_tr_b16 v[72:73], v53 offset:0
  ds_read_b64_tr_b16 v[74:75], v53 offset:1024
  ds_read_b128 v[64:67], v54 offset:38080
  ds_read_b64_tr_b16 v[76:77], v53 offset:8192
  ds_read_b64_tr_b16 v[78:79], v53 offset:9216
  ds_read_b128 v[80:83], v50 offset:0
  ds_read_b128 v[84:87], v50 offset:128
  s_waitcnt lgkmcnt(5)
  v_mfma_f32_16x16x32_bf16 v[88:91], v[72:75], v[60:63], 0
  s_waitcnt lgkmcnt(2)
  v_mfma_f32_16x16x32_bf16 v[88:91], v[76:79], v[64:67], v[88:91]
  v_mov_b32 v68, s58
  s_waitcnt lgkmcnt(0)
  v_add3_u32 v80, v80, v81, v82
  v_add3_u32 v84, v84, v85, v86
  v_add3_u32 v80, v80, v83, v87
  v_add_u32 v80, v80, v84
  s_nop 1
  v_add_u32_dpp v80, v80, v80 quad_perm:[1,0,3,2] row_mask:0xf bank_mask:0xf
  v_cvt_pk_bf16_f32 v92, v88, v89
  v_cvt_pk_bf16_f32 v93, v90, v91
  v_add_u32_dpp v80, v80, v80 quad_perm:[2,3,0,1] row_mask:0xf bank_mask:0xf
  s_mov_b64 exec, s[54:55]
  ds_write_b64 v45, v[92:93] offset:35072
  s_mov_b64 exec, -1
  v_add_u32_dpp v80, v80, v80 row_half_mirror row_mask:0xf bank_mask:0xf
  s_nop 0
  v_cmp_ne_u32 vcc, v80, v58
  s_and_b64 exec, exec, vcc
  s_cbranch_execz L_w_onan
  ds_max_u32 v7, v68 offset:38400
L_w_onan:
  s_mov_b64 exec, -1
  s_waitcnt lgkmcnt(0)
  s_barrier
  ds_read_b32 v68, v7 offset:38400
  ds_read_b128 v[72:75], v33 offset:35072
  ds_read_b128 v[76:79], v33 offset:35136
  ds_read_b128 v[80:83], v33 offset:35200
  ds_read_b128 v[84:87], v33 offset:35264
  s_add_u32 s48, s62, 458752
  s_add_u32 s49, s62, 589824
  s_waitcnt lgkmcnt(3)
  v_mfma_f32_16x16x32_bf16 v[88:91], v[96:99], v[72:75], 0
  v_readfirstlane_b32 s45, v68
  s_waitcnt lgkmcnt(2)
  v_mfma_f32_16x16x32_bf16 v[88:91], v[100:103], v[76:79], v[88:91]
  s_waitcnt lgkmcnt(1)
  v_mfma_f32_16x16x32_bf16 v[88:91], v[104:107], v[80:83], v[88:91]
  s_waitcnt lgkmcnt(0)
  v_mfma_f32_16x16x32_bf16 v[88:91], v[108:111], v[84:87], v[88:91]
  s_cmp_lg_u32 s45, s58
  s_cbranch_scc1 L_w_ook
  s_cmp_lt_u32 s58, 65536
  s_cbranch_scc1 L_w_oretry
L_w_ook:
  s_nop 5
  v_perm_b32 v92, v88, v91, s50
  v_perm_b32 v93, v89, v91, s51
  v_perm_b32 v94, v90, v91, s52
  v_mov_b32 v95, s44
  s_mov_b64 exec, s[54:55]
  buffer_store_dwordx4 v[92:95], v34, s[12:15], s48 offen
  buffer_store_dwordx4 v[92:95], v34, s[12:15], s49 offen sc1
L_w_fin:
  s_endpgm
L_A:
  s_load_dwordx2 s[20:21], s[0:1], 24
  s_lshl_b32 s18, 1, 22
  s_lshl_b32 s19, 1, 17
  s_mov_b32 s22, 4194304
  s_mov_b32 s23, 0x00020000
  s_and_b32 s45, s4, 15
  s_lshl_b32 s45, s45, 18
  s_lshl_b32 s46, s3, 10
  s_add_u32 s45, s45, s46
  v_and_b32 v4, 31, v0
  v_lshlrev_b32 v4, 13, v4
  v_bfe_u32 v5, v0, 5, 1
  v_lshl_add_u32 v4, v5, 7, v4
  s_add_u32 s45, s45, 256
  s_waitcnt lgkmcnt(0)
  s_cmp_gt_u32 s5, 1
  s_cbranch_scc1 L_a_nopf
  s_cmp_eq_u32 s5, 1
  s_cbranch_scc1 L_a_pf1
  buffer_load_dword v253, v4, s[16:19], s45 offen
  s_branch L_a_nopf
L_a_pf1:
  buffer_load_dword v253, v4, s[20:23], s45 offen
L_a_nopf:
  s_load_dwordx2 s[16:17], s[0:1], 8
  s_load_dwordx2 s[12:13], s[0:1], 88
  s_load_dwordx2 s[28:29], s[0:1], 40
  s_load_dwordx2 s[36:37], s[0:1], 64
  s_load_dwordx2 s[40:41], s[0:1], 72
  s_mov_b32 s18, 8388608
  s_mov_b32 s19, 0x00020000
  s_mov_b32 s14, 268435456
  s_mov_b32 s15, 0x00020000
  v_and_b32 v1, 63, v0
  v_mov_b32 v7, 0
  v_lshlrev_b32 v8, 4, v1
  s_sub_u32 s45, s4, 16
  s_and_b32 s57, s45, 1
  s_lshr_b32 s45, s45, 1
  s_lshl_b32 s58, s3, 3
  s_add_u32 s58, s58, s45
  s_lshl_b32 s45, s5, 1
  v_xor_b32 v10, s45, v1
  v_lshlrev_b32 v10, 4, v10
  s_xor_b32 s45, s45, 9
  v_xor_b32 v11, s45, v1
  v_lshlrev_b32 v11, 4, v11
  s_lshl_b32 s59, s58, 17
  s_lshl_b32 s61, s57, 20
  s_lshl_b32 s45, s58, 8
  s_add_u32 s61, s61, s45
  s_add_u32 s61, s61, 1048576
  s_waitcnt lgkmcnt(0)
  s_load_dword s44, s[12:13], 0
  v_and_b32 v238, 7, v1
  v_lshlrev_b32 v238, 7, v238
  s_lshl_b32 s62, s57, 13
  s_lshl_b32 s45, s5, 10
  s_add_u32 s62, s62, s45
  s_add_u32 s62, s62, 16384
  v_lshrrev_b32 v4, 3, v2
  v_and_b32 v5, 7, v2
  v_lshlrev_b32 v12, 2, v4
  v_xor_b32 v5, v5, v12
  v_lshl_or_b32 v5, v5, 1, v4
  v_xor_b32 v5, v5, v3
  v_lshlrev_b32 v5, 4, v5
  v_lshl_add_u32 v5, v2, 10, v5
  s_lshl_b32 s45, s5, 14
  v_add_u32 v12, s45, v5
  v_xor_b32 v13, 0x40, v12
  v_xor_b32 v14, 0x80, v12
  v_xor_b32 v15, 0xc0, v12
  v_add_u32 v20, 131072, v5
  v_xor_b32 v21, 0x40, v20
  v_xor_b32 v22, 0x80, v20
  v_xor_b32 v23, 0xc0, v20
  v_lshrrev_b32 v4, 2, v2
  v_lshl_add_u32 v4, v3, 2, v4
  v_lshrrev_b32 v5, 3, v4
  v_and_b32 v16, 7, v4
  v_lshlrev_b32 v17, 2, v5
  v_xor_b32 v16, v16, v17
  v_lshl_or_b32 v16, v16, 1, v5
  v_bfe_u32 v5, v2, 1, 1
  v_xor_b32 v16, v16, v5
  s_and_b32 s45, s5, 1
  s_lshl_b32 s45, s45, 3
  v_xor_b32 v16, s45, v16
  v_lshlrev_b32 v16, 4, v16
  v_and_b32 v5, 1, v2
  v_lshl_add_u32 v16, v5, 3, v16
  v_lshl_add_u32 v16, v4, 10, v16
  s_lshr_b32 s45, s5, 1
  s_lshl_b32 s45, s45, 8
  v_add_u32 v16, s45, v16
  v_xor_b32 v17, 0x20, v16
  v_xor_b32 v18, 0x40, v16
  v_xor_b32 v19, 0x60, v16
  v_add_u32 v24, 0x10000, v16
  v_add_u32 v25, 0x10000, v17
  v_add_u32 v26, 0x10000, v18
  v_add_u32 v27, 0x10000, v19
  s_lshl_b32 s45, s5, 2
  s_and_b32 s46, s45, 15
  s_cmp_gt_u32 s5, 3
  s_cselect_b32 s47, 9, 0
  s_xor_b32 s46, s46, s47
  v_xor_b32 v28, s46, v1
  v_lshlrev_b32 v28, 4, v28
  s_lshl_b32 s45, s5, 11
  s_add_u32 s45, s45, 131072
  v_add_u32 v28, s45, v28
  v_xor_b32 v29, 0x20, v28
  v_lshlrev_b32 v30, 2, v2
  v_add_u32 v30, 151552, v30
  v_mov_b32 v4, 0xff800000
  ds_write_b32 v30, v4
  v_lshlrev_b32 v242, 2, v1
  v_add_u32 v242, 152064, v242
  s_lshl_b32 s45, s5, 8
  v_add_u32 v254, s45, v242
  s_lshr_b32 s45, s5, 1
  s_lshl_b32 s45, s45, 10
  s_and_b32 s46, s5, 1
  s_lshl_b32 s46, s46, 3
  s_add_u32 s45, s45, s46
  s_add_u32 s45, s45, 147456
  v_add_u32 v31, s45, v8
  v_add_u32 v236, 147456, v8
  v_lshrrev_b32 v246, 1, v3
  v_and_b32 v4, 7, v2
  v_xor_b32 v246, v246, v4
  v_lshlrev_b32 v246, 4, v246
  v_and_b32 v4, 1, v3
  v_lshl_add_u32 v246, v4, 3, v246
  v_lshl_add_u32 v246, v2, 7, v246
  s_lshl_b32 s45, s5, 11
  s_add_u32 s45, s45, 65536
  v_add_u32 v246, s45, v246
  v_xor_b32 v247, 0x20, v246
  v_xor_b32 v240, 0x40, v246
  v_xor_b32 v241, 0x60, v246
  v_lshrrev_b32 v4, 3, v1
  v_and_b32 v5, 7, v1
  v_xor_b32 v248, v4, v5
  v_lshlrev_b32 v248, 4, v248
  v_lshl_add_u32 v248, v4, 7, v248
  v_add_u32 v248, s45, v248
  v_lshlrev_b32 v237, 16, v4
  v_lshl_add_u32 v237, v5, 4, v237
  s_lshl_b32 s45, s5, 8
  s_add_u32 s45, s45, 81920
  v_lshl_add_u32 v249, v1, 2, s45
  v_lshlrev_b32 v9, 9, v3
  v_lshl_add_u32 v9, v2, 2, v9
  v_add_u32 v9, 81920, v9
  s_lshr_b32 s45, s5, 1
  s_lshl_b32 s45, s45, 14
  s_add_u32 s61, s61, s45
  s_and_b32 s45, s5, 1
  s_lshl_b32 s45, s45, 7
  s_add_u32 s61, s61, s45
  s_lshr_b32 s45, s3, 2
  s_lshl_b32 s63, s45, 15
  s_lshl_b32 s45, s57, 14
  s_add_u32 s63, s63, s45
  s_lshl_b32 s45, s5, 11
  s_add_u32 s63, s63, s45
  s_add_u32 s63, s63, 327680
  s_lshl_b32 s96, s57, 6
  s_add_u32 s96, s96, s58
  s_lshl_b32 s96, s96, 10
  s_add_u32 s96, s96, 3407872
  s_mov_b32 s97, 0x3e0293ee
  s_mov_b32 s10, 2048
  s_mov_b32 s11, 0x00020000
  s_mov_b32 s30, 4194304
  s_mov_b32 s31, 0x00020000
  s_mov_b32 s38, 1409024
  s_mov_b32 s39, 0x00020000
  s_mov_b32 s42, 2048
  s_mov_b32 s43, 0x00020000
  s_mov_b32 s50, 0x07060501
  s_mov_b32 s51, 0x07060502
  s_mov_b32 s52, 0x07060503
  s_mov_b32 s53, 0x0c04000c
  s_mov_b32 s54, 0x00030003
  s_mov_b32 s55, 0x00030003
  s_and_b32 s99, s4, 15
  s_lshr_b32 s98, s99, 1
  s_lshl_b32 s99, s98, 7
  v_and_b32 v243, 7, v1
  v_and_b32 v244, 1, v3
  v_lshlrev_b32 v244, 1, v244
  v_xor_b32 v243, v243, v244
  v_lshlrev_b32 v243, 4, v243
  v_lshrrev_b32 v244, 3, v1
  v_lshl_add_u32 v243, v244, 10, v243
  v_xor_b32 v244, 64, v243
  s_and_b32 s45, s5, 1
  s_lshl_b32 s45, s45, 6
  v_xor_b32 v245, s45, v243
  s_mul_i32 s100, s3, 11
  s_sub_u32 s45, s3, 6
  s_max_i32 s45, s45, 0
  s_sub_u32 s100, s100, s45
  s_lshl_b32 s100, s100, 4
  s_mul_i32 s45, s57, 96
  s_add_u32 s100, s100, s45
  s_lshl_b32 s45, s5, 3
  s_add_u32 s100, s100, s45
  s_lshl_b32 s100, s100, 10
  s_add_u32 s100, s100, s99
  s_lshl_b32 s101, s3, 19
  s_lshl_b32 s45, s57, 18
  s_add_u32 s101, s101, s45
  s_lshl_b32 s45, s5, 15
  s_add_u32 s101, s101, s45
  s_add_u32 s101, s101, s99
  v_lshlrev_b32 v255, 7, v1
  s_and_b32 s46, s4, 15
  s_lshl_b32 s47, s3, 19
  s_lshl_b32 s45, s46, 15
  s_add_u32 s47, s47, s45
  s_lshl_b32 s45, s5, 13
  s_add_u32 s47, s47, s45
  s_mov_b32 s20, s28
  s_mov_b32 s21, s29
  s_cmp_lt_u32 s5, 4
  s_cselect_b32 s22, s30, 0
  s_mov_b32 s23, 0x00020000
  s_waitcnt vmcnt(0)
  s_barrier
  s_lshl_b32 s60, s57, 15
  s_lshl_b32 s48, s5, 10
  s_add_u32 s60, s60, s48
  s_xor_b32 s46, s60, 0x8000
  s_add_u32 s60, s60, s59
  s_add_u32 s46, s46, s59
  s_add_u32 m0, s48, 0
  s_add_u32 s45, s60, 0
  buffer_load_dwordx4 v10, s[16:19], s45 offen  lds
  s_add_u32 m0, s48, 8192
  s_add_u32 s45, s60, 8192
  buffer_load_dwordx4 v11, s[16:19], s45 offen  lds
  s_add_u32 m0, s48, 16384
  s_add_u32 s45, s60, 16384
  buffer_load_dwordx4 v10, s[16:19], s45 offen  lds
  s_add_u32 m0, s48, 24576
  s_add_u32 s45, s60, 24576
  buffer_load_dwordx4 v11, s[16:19], s45 offen  lds
  s_waitcnt vmcnt(3)
  s_add_u32 m0, s48, 32768
  s_add_u32 s45, s46, 0
  buffer_load_dwordx4 v10, s[16:19], s45 offen  lds
  s_waitcnt vmcnt(3)
  s_add_u32 m0, s48, 40960
  s_add_u32 s45, s46, 8192
  buffer_load_dwordx4 v11, s[16:19], s45 offen  lds
  s_waitcnt vmcnt(3)
  s_add_u32 m0, s48, 49152
  s_add_u32 s45, s46, 16384
  buffer_load_dwordx4 v10, s[16:19], s45 offen  lds
  s_waitcnt vmcnt(3)
  s_add_u32 m0, s48, 57344
  s_add_u32 s45, s46, 24576
  buffer_load_dwordx4 v11, s[16:19], s45 offen  lds
  s_waitcnt vmcnt(3)
  s_add_u32 m0, s48, 65536
  s_add_u32 s45, s60, 65536
  buffer_load_dwordx4 v10, s[16:19], s45 offen  lds
  s_waitcnt vmcnt(3)
  s_add_u32 m0, s48, 73728
  s_add_u32 s45, s60, 73728
  buffer_load_dwordx4 v11, s[16:19], s45 offen  lds
  s_waitcnt vmcnt(3)
  s_add_u32 m0, s48, 81920
  s_add_u32 s45, s60, 81920
  buffer_load_dwordx4 v10, s[16:19], s45 offen  lds
  s_waitcnt vmcnt(3)
  s_add_u32 m0, s48, 90112
  s_add_u32 s45, s60, 90112
  buffer_load_dwordx4 v11, s[16:19], s45 offen  lds
  s_waitcnt vmcnt(3)
  buffer_load_dword v239, v238, s[12:15], s62 offen sc1
  s_add_u32 m0, s48, 98304
  s_add_u32 s45, s46, 65536
  buffer_load_dwordx4 v10, s[16:19], s45 offen  lds
  s_add_u32 m0, s48, 106496
  s_add_u32 s45, s46, 73728
  buffer_load_dwordx4 v11, s[16:19], s45 offen  lds
  s_add_u32 m0, s48, 114688
  s_add_u32 s45, s46, 81920
  buffer_load_dwordx4 v10, s[16:19], s45 offen  lds
  s_add_u32 m0, s48, 122880
  s_add_u32 s45, s46, 90112
  buffer_load_dwordx4 v11, s[16:19], s45 offen  lds
  s_waitcnt lgkmcnt(0)
  s_add_u32 s44, s44, 1
  s_mov_b32 s56, 0
  s_waitcnt vmcnt(9)
  s_barrier
  s_cmp_gt_u32 s5, 3
  s_cbranch_scc1 L_a_ar1
  ds_read_b128 v[32:35], v12 offset:0
  ds_read_b128 v[36:39], v13 offset:0
  ds_read_b128 v[40:43], v14 offset:0
  ds_read_b128 v[44:47], v15 offset:0
  ds_read_b128 v[48:51], v12 offset:256
  ds_read_b128 v[52:55], v13 offset:256
  ds_read_b128 v[56:59], v14 offset:256
  ds_read_b128 v[60:63], v15 offset:256
  ds_read_b128 v[64:67], v12 offset:512
  ds_read_b128 v[68:71], v13 offset:512
  ds_read_b128 v[72:75], v14 offset:512
  ds_read_b128 v[76:79], v15 offset:512
  ds_read_b128 v[80:83], v12 offset:768
  ds_read_b128 v[84:87], v13 offset:768
  ds_read_b128 v[88:91], v14 offset:768
  ds_read_b128 v[92:95], v15 offset:768
L_a_ar1:
  ds_read_b64_tr_b16 v[96:97], v16 offset:0
  ds_read_b64_tr_b16 v[98:99], v16 offset:16384
  ds_read_b64_tr_b16 v[112:113], v17 offset:0
  ds_read_b64_tr_b16 v[114:115], v17 offset:16384
  ds_read_b64_tr_b16 v[128:129], v18 offset:0
  ds_read_b64_tr_b16 v[130:131], v18 offset:16384
  ds_read_b64_tr_b16 v[144:145], v19 offset:0
  ds_read_b64_tr_b16 v[146:147], v19 offset:16384
  ds_read_b64_tr_b16 v[100:101], v16 offset:32768
  ds_read_b64_tr_b16 v[102:103], v16 offset:49152
  ds_read_b64_tr_b16 v[116:117], v17 offset:32768
  ds_read_b64_tr_b16 v[118:119], v17 offset:49152
  ds_read_b64_tr_b16 v[132:133], v18 offset:32768
  ds_read_b64_tr_b16 v[134:135], v18 offset:49152
  ds_read_b64_tr_b16 v[148:149], v19 offset:32768
  ds_read_b64_tr_b16 v[150:151], v19 offset:49152
  s_waitcnt vmcnt(4)
  v_cmp_ne_u32 vcc, s44, v239
  s_mov_b64 s[48:49], vcc
  s_cmp_lg_u64 s[48:49], 0
  s_cbranch_scc1 L_a_q1
  s_waitcnt vmcnt(1)
  buffer_load_dwordx4 v[224:227], v8, s[12:15], s63 offen sc1
  buffer_load_dwordx4 v[228:231], v8, s[12:15], s63 offen offset:1024 sc1
L_a_q1:
  s_waitcnt vmcnt(2)
  s_cmp_eq_u64 s[48:49], 0
  s_cbranch_scc1 L_a_land
  s_waitcnt vmcnt(0)
L_a_land:
  s_barrier
  s_cmp_lg_u64 s[48:49], 0
  s_cbranch_scc1 L_a_slow0
  s_waitcnt vmcnt(0)
  v_max3_u32 v4, v224, v225, v226
  v_max3_u32 v5, v227, v228, v229
  v_max3_u32 v4, v4, v230, v231
  v_max_u32 v4, v4, v5
  v_cmp_eq_u32 vcc, -1, v4
  s_cbranch_vccz L_a_fast
  buffer_load_dwordx4 v[224:227], v8, s[12:15], s63 offen sc1
  buffer_load_dwordx4 v[228:231], v8, s[12:15], s63 offen offset:1024 sc1
L_a_slow0:
  s_cmp_le_u32 s5, 3
  s_cbranch_scc1 L_a_ar2
  ds_read_b128 v[32:35], v12 offset:0
  ds_read_b128 v[36:39], v13 offset:0
  ds_read_b128 v[40:43], v14 offset:0
  ds_read_b128 v[44:47], v15 offset:0
  ds_read_b128 v[48:51], v12 offset:256
  ds_read_b128 v[52:55], v13 offset:256
  ds_read_b128 v[56:59], v14 offset:256
  ds_read_b128 v[60:63], v15 offset:256
  ds_read_b128 v[64:67], v12 offset:512
  ds_read_b128 v[68:71], v13 offset:512
  ds_read_b128 v[72:75], v14 offset:512
  ds_read_b128 v[76:79], v15 offset:512
  ds_read_b128 v[80:83], v12 offset:768
  ds_read_b128 v[84:87], v13 offset:768
  ds_read_b128 v[88:91], v14 offset:768
  ds_read_b128 v[92:95], v15 offset:768
L_a_ar2:
  s_cmp_eq_u64 s[48:49], 0
  s_cbranch_scc1 L_a_q
L_a_flg:
  buffer_load_dword v239, v238, s[12:15], s62 offen sc1
  s_add_u32 s56, s56, 1
  s_waitcnt vmcnt(0)
  v_cmp_ne_u32 vcc, s44, v239
  s_cbranch_vccz L_a_qre
  s_cmp_lt_u32 s56, 262144
  s_cbranch_scc1 L_a_flg
L_a_qre:
  buffer_load_dwordx4 v[224:227], v8, s[12:15], s63 offen sc1
  buffer_load_dwordx4 v[228:231], v8, s[12:15], s63 offen offset:1024 sc1
L_a_q:
  s_waitcnt vmcnt(0)
  v_max3_u32 v4, v224, v225, v226
  v_max3_u32 v5, v227, v228, v229
  v_max3_u32 v4, v4, v230, v231
  v_max_u32 v4, v4, v5
  v_cmp_eq_u32 vcc, -1, v4
  s_cbranch_vccz L_a_qok
  s_add_u32 s56, s56, 1
  s_cmp_lt_u32 s56, 262144
  s_cbranch_scc1 L_a_qre
L_a_qok:
  ds_write_b128 v28, v[224:227]
  ds_write_b128 v29, v[228:231] offset:1024
  s_waitcnt lgkmcnt(0)
  s_branch L_a_qk
L_a_fast:
  ds_write_b128 v28, v[224:227]
  ds_write_b128 v29, v[228:231] offset:1024
  s_cmp_gt_u32 s5, 3
  s_cbranch_scc1 L_a_ar3
  s_waitcnt lgkmcnt(0)
  s_branch L_a_qk
L_a_ar3:
  ds_read_b128 v[32:35], v12 offset:0
  ds_read_b128 v[36:39], v13 offset:0
  ds_read_b128 v[40:43], v14 offset:0
  ds_read_b128 v[44:47], v15 offset:0
  ds_read_b128 v[48:51], v12 offset:256
  ds_read_b128 v[52:55], v13 offset:256
  ds_read_b128 v[56:59], v14 offset:256
  ds_read_b128 v[60:63], v15 offset:256
  ds_read_b128 v[64:67], v12 offset:512
  ds_read_b128 v[68:71], v13 offset:512
  ds_read_b128 v[72:75], v14 offset:512
  ds_read_b128 v[76:79], v15 offset:512
  ds_read_b128 v[80:83], v12 offset:768
  ds_read_b128 v[84:87], v13 offset:768
  ds_read_b128 v[88:91], v14 offset:768
  ds_read_b128 v[92:95], v15 offset:768
  s_waitcnt lgkmcnt(15)
L_a_qk:
  s_barrier
  ds_read_b128 v[160:163], v20 offset:0
  ds_read_b128 v[164:167], v21 offset:0
  ds_read_b128 v[168:171], v22 offset:0
  ds_read_b128 v[172:175], v23 offset:0
  ds_read_b128 v[176:179], v20 offset:256
  ds_read_b128 v[180:183], v21 offset:256
  ds_read_b128 v[184:187], v22 offset:256
  ds_read_b128 v[188:191], v23 offset:256
  ds_read_b128 v[192:195], v20 offset:512
  ds_read_b128 v[196:199], v21 offset:512
  ds_read_b128 v[200:203], v22 offset:512
  ds_read_b128 v[204:207], v23 offset:512
  buffer_load_dword v253, v255, s[20:23], s47 offen
  s_waitcnt lgkmcnt(11)
  v_mfma_f32_16x16x32_bf16 v[232:235], v[32:35], v[160:163], 0
  ds_read_b128 v[208:211], v20 offset:768
  s_waitcnt lgkmcnt(11)
  v_mfma_f32_16x16x32_bf16 v[232:235], v[36:39], v[164:167], v[232:235]
  ds_read_b128 v[212:215], v21 offset:768
  s_waitcnt lgkmcnt(11)
  v_mfma_f32_16x16x32_bf16 v[232:235], v[40:43], v[168:171], v[232:235]
  ds_read_b128 v[216:219], v22 offset:768
  s_waitcnt lgkmcnt(11)
  v_mfma_f32_16x16x32_bf16 v[232:235], v[44:47], v[172:175], v[232:235]
  ds_read_b128 v[220:223], v23 offset:768
  ds_read_b64_tr_b16 v[104:105], v24 offset:0
  ds_read_b64_tr_b16 v[106:107], v24 offset:16384
  ds_read_b64_tr_b16 v[120:121], v25 offset:0
  ds_read_b64_tr_b16 v[122:123], v25 offset:16384
  s_waitcnt lgkmcnt(15)
  v_mfma_f32_16x16x32_bf16 v[232:235], v[48:51], v[176:179], v[232:235]
  ds_read_b64_tr_b16 v[136:137], v26 offset:0
  s_waitcnt lgkmcnt(15)
  v_mfma_f32_16x16x32_bf16 v[232:235], v[52:55], v[180:183], v[232:235]
  ds_read_b64_tr_b16 v[138:139], v26 offset:16384
  s_waitcnt lgkmcnt(15)
  v_mfma_f32_16x16x32_bf16 v[232:235], v[56:59], v[184:187], v[232:235]
  ds_read_b64_tr_b16 v[152:153], v27 offset:0
  s_waitcnt lgkmcnt(15)
  v_mfma_f32_16x16x32_bf16 v[232:235], v[60:63], v[188:191], v[232:235]
  ds_read_b64_tr_b16 v[154:155], v27 offset:16384
  s_waitcnt lgkmcnt(15)
  v_mfma_f32_16x16x32_bf16 v[232:235], v[64:67], v[192:195], v[232:235]
  ds_read_b64_tr_b16 v[108:109], v24 offset:32768
  s_waitcnt lgkmcnt(15)
  v_mfma_f32_16x16x32_bf16 v[232:235], v[68:71], v[196:199], v[232:235]
  ds_read_b64_tr_b16 v[110:111], v24 offset:49152
  s_waitcnt lgkmcnt(15)
  v_mfma_f32_16x16x32_bf16 v[232:235], v[72:75], v[200:203], v[232:235]
  ds_read_b64_tr_b16 v[124:125], v25 offset:32768
  s_waitcnt lgkmcnt(15)
  v_mfma_f32_16x16x32_bf16 v[232:235], v[76:79], v[204:207], v[232:235]
  ds_read_b64_tr_b16 v[126:127], v25 offset:49152
  s_waitcnt lgkmcnt(15)
  v_mfma_f32_16x16x32_bf16 v[232:235], v[80:83], v[208:211], v[232:235]
  ds_read_b64_tr_b16 v[140:141], v26 offset:32768
  s_waitcnt lgkmcnt(15)
  v_mfma_f32_16x16x32_bf16 v[232:235], v[84:87], v[212:215], v[232:235]
  ds_read_b64_tr_b16 v[142:143], v26 offset:49152
  s_waitcnt lgkmcnt(15)
  v_mfma_f32_16x16x32_bf16 v[232:235], v[88:91], v[216:219], v[232:235]
  ds_read_b64_tr_b16 v[156:157], v27 offset:32768
  s_waitcnt lgkmcnt(15)
  v_mfma_f32_16x16x32_bf16 v[232:235], v[92:95], v[220:223], v[232:235]
  s_nop 7
  v_max3_f32 v4, v232, v233, v234
  v_max_f32 v4, v4, v235
  ds_max_f32 v30, v4
  ds_read_b64_tr_b16 v[158:159], v27 offset:49152
  s_waitcnt lgkmcnt(1)
  s_barrier
  ds_read_b32 v4, v30
  s_waitcnt lgkmcnt(0)
L_a_sm:
  v_mul_f32 v4, s97, v4
  v_fma_f32 v232, v232, s97, -v4
  v_fma_f32 v233, v233, s97, -v4
  v_fma_f32 v234, v234, s97, -v4
  v_fma_f32 v235, v235, s97, -v4
  v_exp_f32 v232, v232
  v_exp_f32 v233, v233
  v_exp_f32 v234, v234
  v_exp_f32 v235, v235
  s_nop 0
  v_cvt_pk_bf16_f32 v160, v232, v233
  v_cvt_pk_bf16_f32 v161, v234, v235
  v_add_f32 v232, v232, v233
  v_add_f32 v234, v234, v235
  ds_write_b64 v31, v[160:161]
  v_add_f32 v232, v232, v234
  ds_write_b32 v254, v232
  s_waitcnt lgkmcnt(0)
  s_barrier
  ds_read_b128 v[160:163], v236 offset:0
  ds_read_b128 v[164:167], v236 offset:1024
  ds_read_b128 v[168:171], v236 offset:2048
  ds_read_b128 v[172:175], v236 offset:3072
  s_waitcnt lgkmcnt(3)
  v_mfma_f32_16x16x32_bf16 v[176:179], v[96:99], v[160:163], 0
  v_mfma_f32_16x16x32_bf16 v[180:183], v[112:115], v[160:163], 0
  s_waitcnt lgkmcnt(2)
  v_mfma_f32_16x16x32_bf16 v[176:179], v[100:103], v[164:167], v[176:179]
  v_mfma_f32_16x16x32_bf16 v[180:183], v[116:119], v[164:167], v[180:183]
  s_waitcnt lgkmcnt(1)
  v_mfma_f32_16x16x32_bf16 v[176:179], v[104:107], v[168:171], v[176:179]
  v_mfma_f32_16x16x32_bf16 v[180:183], v[120:123], v[168:171], v[180:183]
  s_waitcnt lgkmcnt(0)
  v_mfma_f32_16x16x32_bf16 v[176:179], v[108:111], v[172:175], v[176:179]
  v_mfma_f32_16x16x32_bf16 v[180:183], v[124:127], v[172:175], v[180:183]
  v_mfma_f32_16x16x32_bf16 v[184:187], v[128:131], v[160:163], 0
  v_mfma_f32_16x16x32_bf16 v[188:191], v[144:147], v[160:163], 0
  v_mfma_f32_16x16x32_bf16 v[184:187], v[132:135], v[164:167], v[184:187]
  v_mfma_f32_16x16x32_bf16 v[188:191], v[148:151], v[164:167], v[188:191]
  v_mfma_f32_16x16x32_bf16 v[184:187], v[136:139], v[168:171], v[184:187]
  v_mfma_f32_16x16x32_bf16 v[188:191], v[152:155], v[168:171], v[188:191]
  s_nop 0
  v_cvt_pk_bf16_f32 v192, v176, v177
  v_cvt_pk_bf16_f32 v193, v178, v179
  ds_write_b64 v246, v[192:193]
  v_mfma_f32_16x16x32_bf16 v[184:187], v[140:143], v[172:175], v[184:187]
  v_cvt_pk_bf16_f32 v194, v180, v181
  v_cvt_pk_bf16_f32 v195, v182, v183
  ds_write_b64 v247, v[194:195]
  v_mfma_f32_16x16x32_bf16 v[188:191], v[156:159], v[172:175], v[188:191]
  s_nop 3
  v_cvt_pk_bf16_f32 v196, v184, v185
  v_cvt_pk_bf16_f32 v197, v186, v187
  ds_write_b64 v240, v[196:197]
  s_nop 0
  v_cvt_pk_bf16_f32 v198, v188, v189
  v_cvt_pk_bf16_f32 v199, v190, v191
  ds_write_b64 v241, v[198:199]
  ds_read_b128 v[208:211], v248
  ds_read_b128 v[212:215], v248 offset:1024
  v_add3_u32 v216, v192, v193, v194
  v_add3_u32 v217, v195, v196, v197
  v_add3_u32 v216, v216, v198, v199
  v_add_u32 v216, v216, v217
  ds_write_b32 v249, v216
  s_add_u32 s45, s61, 0x80000
  s_waitcnt lgkmcnt(2)
  buffer_store_dwordx4 v[208:211], v237, s[12:15], s61 offen sc1
  s_waitcnt lgkmcnt(1)
  buffer_store_dwordx4 v[212:215], v237, s[12:15], s45 offen sc1
  s_cmp_eq_u32 s5, 0
  s_cbranch_scc1 L_a_stat
  s_waitcnt lgkmcnt(0)
  s_barrier
  s_branch L_a_nost
L_a_stat:
  ds_read2st64_b32 v[200:201], v242 offset0:0 offset1:1
  ds_read2st64_b32 v[202:203], v242 offset0:2 offset1:3
  ds_read2st64_b32 v[204:205], v242 offset0:4 offset1:5
  ds_read2st64_b32 v[206:207], v242 offset0:6 offset1:7
  v_mov_b32 v7, s44
  s_waitcnt lgkmcnt(0)
  v_add_f32 v200, v200, v201
  v_add_f32 v202, v202, v203
  v_add_f32 v204, v204, v205
  v_add_f32 v206, v206, v207
  v_add_f32 v200, v200, v202
  v_add_f32 v204, v204, v206
  v_add_f32 v5, v200, v204
  v_mov_b32 v200, v5
  s_nop 1
  v_permlane16_swap_b32 v5, v200
  s_nop 0
  v_add_f32 v5, v5, v200
  v_mov_b32 v200, v5
  s_nop 1
  v_permlane32_swap_b32 v5, v200
  s_nop 0
  v_add_f32 v5, v5, v200
  v_lshrrev_b32 v242, 2, v2
  v_lshlrev_b32 v242, 8, v242
  v_lshl_add_u32 v242, v3, 6, v242
  v_and_b32 v200, 3, v2
  v_lshl_add_u32 v242, v200, 4, v242
  s_barrier
  ds_read2_b32 v[216:217], v9 offset0:0 offset1:16
  ds_read2_b32 v[218:219], v9 offset0:32 offset1:48
  ds_read2_b32 v[220:221], v9 offset0:64 offset1:80
  ds_read2_b32 v[222:223], v9 offset0:96 offset1:112
  s_waitcnt lgkmcnt(2)
  v_add3_u32 v6, v216, v217, v218
  s_waitcnt lgkmcnt(0)
  v_add3_u32 v220, v220, v221, v222
  v_add3_u32 v6, v6, v219, v223
  v_add_u32 v6, v6, v220
  buffer_store_dwordx4 v[4:7], v242, s[12:15], s96 offen sc1
L_a_nost:
  s_lshl_b32 s46, s5, 12
  s_add_u32 m0, s46, 0
  s_add_u32 s45, s101, 0
  buffer_load_dwordx4 v243, s[28:31], s45 offen  lds
  s_add_u32 m0, s46, 1024
  s_add_u32 s45, s101, 8192
  buffer_load_dwordx4 v244, s[28:31], s45 offen  lds
  s_add_u32 m0, s46, 2048
  s_add_u32 s45, s101, 16384
  buffer_load_dwordx4 v243, s[28:31], s45 offen  lds
  s_add_u32 m0, s46, 3072
  s_add_u32 s45, s101, 24576
  buffer_load_dwordx4 v244, s[28:31], s45 offen  lds
  s_lshl_b32 s46, s5, 10
  s_add_u32 m0, s46, 32768
  s_cmp_gt_u32 s5, 3
  buffer_load_dwordx4 v245, s[36:39], s100 offen  lds
  s_cbranch_scc1 L_a_now2
  s_add_u32 m0, s46, 40960
  s_add_u32 s45, s100, 65536
  buffer_load_dwordx4 v245, s[36:39], s45 offen  lds
L_a_now2:
  v_lshrrev_b32 v4, 2, v2
  v_and_b32 v5, 3, v2
  v_lshl_add_u32 v31, v3, 3, v4
  v_lshrrev_b32 v50, 1, v4
  v_and_b32 v51, 1, v3
  v_lshl_or_b32 v50, v51, 1, v50
  s_and_b32 s45, s5, 3
  v_xor_b32 v50, s45, v50
  v_lshlrev_b32 v50, 5, v50
  v_lshl_add_u32 v50, v5, 3, v50
  v_lshl_add_u32 v50, v31, 7, v50
  v_and_b32 v32, 1, v2
  v_lshrrev_b32 v36, 1, v2
  v_lshlrev_b32 v36, 3, v36
  v_lshl_add_u32 v36, v3, 1, v36
  s_lshl_b32 s45, s5, 6
  v_add_u32 v36, s45, v36
  v_mul_u32_u24 v38, 832, v32
  v_add_u32 v36, v36, v38
  v_lshrrev_b32 v35, 1, v1
  v_lshl_add_u32 v35, v35, 3, v38
  s_and_b32 s45, s5, 1
  s_lshl_b32 s45, s45, 8
  v_add_u32 v35, s45, v35
  v_lshl_add_u32 v38, v3, 4, v38
  v_lshlrev_b32 v49, 3, v2
  v_lshl_add_u32 v49, v3, 1, v49
  s_lshl_b32 s100, s57, 10
  s_add_u32 s100, s100, s99
  buffer_load_ushort v180, v49, s[8:11], s100 offen
  v_lshlrev_b32 v92, 12, v3
  v_lshl_add_u32 v92, v2, 4, v92
  v_lshlrev_b32 v93, 8, v2
  v_lshl_add_u32 v93, v3, 4, v93
  s_lshl_b32 s46, s5, 6
  v_add_u32 v93, s46, v93
  s_lshl_b32 s59, s98, 13
  s_lshl_b32 s46, s3, 9
  s_add_u32 s59, s59, s46
  s_lshl_b32 s46, s57, 8
  s_add_u32 s59, s59, s46
  s_add_u32 s59, s59, 720896
  s_lshl_b32 s60, s3, 14
  s_lshl_b32 s47, s57, 13
  s_add_u32 s60, s60, s47
  v_lshlrev_b32 v34, 10, v3
  v_lshl_add_u32 v34, v2, 4, v34
  s_lshr_b32 s47, s5, 2
  s_lshl_b32 s47, s47, 12
  s_add_u32 s60, s60, s47
  s_and_b32 s47, s5, 3
  s_lshl_b32 s47, s47, 8
  s_add_u32 s60, s60, s47
  s_add_u32 s61, s60, 589824
  s_add_u32 s60, s60, 458752
  s_cmp_lt_u32 s5, 4
  s_cbranch_scc1 L_a_nohg
  s_cmp_eq_u32 s5, 7
  s_cbranch_scc1 L_a_nohg
  s_cmp_ge_u32 s3, 6
  s_cselect_b32 s45, 10, 11
  s_lshl_b32 s45, s45, 3
  s_mul_i32 s46, s57, 48
  s_sub_u32 s45, s45, s46
  s_lshl_b32 s46, s5, 4
  s_sub_u32 s46, s46, 64
  v_add_u32 v60, s46, v2
  v_cmp_gt_u32 s[46:47], s45, v60
  s_lshl_b32 s48, s3, 15
  s_mul_i32 s49, s57, 768
  s_add_u32 s48, s48, s49
  s_lshl_b32 s49, s5, 8
  s_add_u32 s48, s48, s49
  s_add_u32 s48, s48, 785408
  s_add_u32 s49, s48, 2359296
  v_lshlrev_b32 v60, 11, v3
  v_lshl_add_u32 v60, v2, 4, v60
  v_add_u32 v61, 0x2000, v60
  v_add_u32 v62, 0x4000, v60
  v_add_u32 v63, 0x6000, v60
  s_mov_b32 s56, 0
  s_mov_b32 s45, s48
L_hh_ld:
  buffer_load_dwordx4 v[64:67], v60, s[12:15], s45 offen offset:0 sc1
  buffer_load_dwordx4 v[68:71], v61, s[12:15], s45 offen offset:0 sc1
  buffer_load_dwordx4 v[72:75], v62, s[12:15], s45 offen offset:0 sc1
  buffer_load_dwordx4 v[76:79], v63, s[12:15], s45 offen offset:0 sc1
  s_add_u32 s56, s56, 1
  s_cmp_gt_u32 s56, 32
  s_cselect_b32 s45, s56, 0
  s_and_b32 s45, s45, 3
  s_cmp_eq_u32 s45, 3
  s_cselect_b32 s45, s49, s48
  s_waitcnt vmcnt(0)
L_hh_chk:
  v_xor_b32 v80, s44, v67
  v_xor_b32 v81, s44, v71
  v_xor_b32 v82, s44, v75
  v_xor_b32 v83, s44, v79
  v_or3_b32 v80, v80, v81, v82
  v_or_b32 v80, v80, v83
  v_cmp_ne_u32 vcc, 0, v80
  s_and_b64 vcc, vcc, s[46:47]
  s_cbranch_scc0 L_hh_ok
  s_cmp_lt_u32 s56, 262144
  s_cbranch_scc1 L_hh_ld
L_hh_ok:
  v_perm_b32 v67, v65, v64, s53
  v_lshl_or_b32 v67, v66, 24, v67
  v_perm_b32 v71, v69, v68, s53
  v_lshl_or_b32 v71, v70, 24, v71
  v_perm_b32 v75, v73, v72, s53
  v_lshl_or_b32 v75, v74, 24, v75
  v_perm_b32 v79, v77, v76, s53
  v_lshl_or_b32 v79, v78, 24, v79
  v_add_f32 v64, v64, v68
  v_add_f32 v72, v72, v76
  v_add_f32 v65, v65, v69
  v_add_f32 v73, v73, v77
  v_add_f32 v66, v66, v70
  v_add_f32 v74, v74, v78
  v_add_f32 v67, v67, v71
  v_add_f32 v75, v75, v79
  v_add_f32 v64, v64, v72
  v_add_f32 v65, v65, v73
  v_add_f32 v66, v66, v74
  v_add_f32 v67, v67, v75
  s_nop 1
  v_permlane32_swap_b32 v64, v66
  v_permlane32_swap_b32 v65, v67
  s_nop 0
  v_add_f32 v64, v64, v66
  v_add_f32 v65, v65, v67
  s_nop 1
  v_permlane16_swap_b32 v64, v65
  s_nop 0
  v_add_f32 v64, v64, v65
  v_cvt_pk_bf16_f32 v64, v64, v64
  v_lshlrev_b32 v64, 16, v64
  v_mul_f32 v65, 0xbfb8aa3b, v64
  v_exp_f32 v65, v65
  s_nop 0
  v_add_f32 v65, 1.0, v65
  v_rcp_f32 v65, v65
  s_nop 0
  v_mul_f32 v64, v64, v65
  v_cndmask_b32 v64, 0, v64, s[46:47]
  v_cvt_pk_bf16_f32 v64, v64, v64
  ds_write_b16 v36, v64 offset:45312
L_a_nohg:
  s_waitcnt vmcnt(0) lgkmcnt(0)
  s_barrier
  s_cmp_gt_u32 s5, 3
  s_cbranch_scc1 L_a_nofrag
  ds_read_b128 v[60:63], v38 offset:45568
  ds_read_b64_tr_b16 v[144:145], v50 offset:32768
  ds_read_b64_tr_b16 v[146:147], v50 offset:33280
  ds_read_b128 v[64:67], v38 offset:45632
  ds_read_b64_tr_b16 v[148:149], v50 offset:36864
  ds_read_b64_tr_b16 v[150:151], v50 offset:37376
  ds_read_b128 v[68:71], v38 offset:45696
  ds_read_b64_tr_b16 v[152:153], v50 offset:40960
  ds_read_b64_tr_b16 v[154:155], v50 offset:41472
  ds_read_b64_tr_b16 v[112:113], v50 offset:0
  ds_read_b64_tr_b16 v[114:115], v50 offset:512
  ds_read_b64_tr_b16 v[116:117], v50 offset:4096
  ds_read_b64_tr_b16 v[118:119], v50 offset:4608
  ds_read_b64_tr_b16 v[120:121], v50 offset:8192
  ds_read_b64_tr_b16 v[122:123], v50 offset:8704
  ds_read_b64_tr_b16 v[124:125], v50 offset:12288
  ds_read_b64_tr_b16 v[126:127], v50 offset:12800
  ds_read_b64_tr_b16 v[128:129], v50 offset:16384
  ds_read_b64_tr_b16 v[130:131], v50 offset:16896
  ds_read_b64_tr_b16 v[132:133], v50 offset:20480
  ds_read_b64_tr_b16 v[134:135], v50 offset:20992
  ds_read_b64_tr_b16 v[136:137], v50 offset:24576
  ds_read_b64_tr_b16 v[138:139], v50 offset:25088
  ds_read_b64_tr_b16 v[140:141], v50 offset:28672
  ds_read_b64_tr_b16 v[142:143], v50 offset:29184
  s_waitcnt lgkmcnt(0)
  v_mfma_f32_16x16x32_bf16 v[176:179], v[144:147], v[60:63], 0
  v_mfma_f32_16x16x32_bf16 v[176:179], v[148:151], v[64:67], v[176:179]
  v_mfma_f32_16x16x32_bf16 v[176:179], v[152:155], v[68:71], v[176:179]
L_a_nofrag:
  s_mov_b32 s56, 0
  buffer_load_dwordx4 v[72:75], v34, s[12:15], s60 offen sc1
  s_waitcnt vmcnt(0)
L_h25_chk:
  v_cmp_ne_u32 vcc, s44, v75
  s_cbranch_vccz L_h25_ok
  s_add_u32 s56, s56, 1
  s_cmp_gt_u32 s56, 262144
  s_cbranch_scc1 L_h25_ok
  s_cmp_gt_u32 s56, 32
  s_cselect_b32 s45, s56, 0
  s_and_b32 s45, s45, 3
  s_cmp_eq_u32 s45, 3
  s_cselect_b32 s45, s61, s60
  buffer_load_dwordx4 v[72:75], v34, s[12:15], s45 offen sc1
  s_waitcnt vmcnt(0)
  s_branch L_h25_chk
L_h25_ok:
  v_perm_b32 v75, v73, v72, s53
  v_lshl_or_b32 v75, v74, 24, v75
  s_nop 1
  v_permlane32_swap_b32 v72, v74
  v_permlane32_swap_b32 v73, v75
  s_nop 0
  v_add_f32 v72, v72, v74
  v_add_f32 v73, v73, v75
  s_nop 1
  v_permlane16_swap_b32 v72, v73
  s_nop 0
  v_add_f32 v72, v72, v73
  v_cvt_pk_bf16_f32 v72, v72, v72
  ds_write_b16 v36, v72 offset:45056
  s_waitcnt lgkmcnt(0)
L_a_noh25:
  s_barrier
  s_cmp_gt_u32 s5, 3
  s_cbranch_scc1 L_a_nop3b
  ds_read_b128 v[56:59], v38 offset:45056
  ds_read_b128 v[60:63], v38 offset:45120
  ds_read_b128 v[64:67], v38 offset:45184
  ds_read_b128 v[68:71], v38 offset:45248
  ds_read_b128 v[72:75], v38 offset:45312
  ds_read_b128 v[76:79], v38 offset:45376
  ds_read_b128 v[80:83], v38 offset:45440
  ds_read_b128 v[84:87], v38 offset:45504
  s_waitcnt lgkmcnt(7)
  v_mfma_f32_16x16x32_bf16 v[176:179], v[112:115], v[56:59], v[176:179]
  s_waitcnt lgkmcnt(6)
  v_mfma_f32_16x16x32_bf16 v[176:179], v[116:119], v[60:63], v[176:179]
  s_waitcnt lgkmcnt(5)
  v_mfma_f32_16x16x32_bf16 v[176:179], v[120:123], v[64:67], v[176:179]
  s_waitcnt lgkmcnt(4)
  v_mfma_f32_16x16x32_bf16 v[176:179], v[124:127], v[68:71], v[176:179]
  s_waitcnt lgkmcnt(3)
  v_mfma_f32_16x16x32_bf16 v[176:179], v[128:131], v[72:75], v[176:179]
  s_waitcnt lgkmcnt(2)
  v_mfma_f32_16x16x32_bf16 v[176:179], v[132:135], v[76:79], v[176:179]
  s_waitcnt lgkmcnt(1)
  v_mfma_f32_16x16x32_bf16 v[176:179], v[136:139], v[80:83], v[176:179]
  s_waitcnt lgkmcnt(0)
  v_mfma_f32_16x16x32_bf16 v[176:179], v[140:143], v[84:87], v[176:179]
  s_nop 7
  v_perm_b32 v88, v176, v179, s50
  v_perm_b32 v89, v177, v179, s51
  v_perm_b32 v90, v178, v179, s52
  v_mov_b32 v91, s44
  s_mov_b64 exec, s[54:55]
  ds_write_b128 v93, v[88:91] offset:47104
  s_mov_b64 exec, -1
  s_waitcnt lgkmcnt(0)
L_a_nop3b:
  s_barrier
  s_cmp_lg_u32 s5, 4
  s_cbranch_scc1 L_a_fin
  s_mov_b32 exec_hi, 0
  ds_read_b128 v[88:91], v8 offset:47104
  s_and_b32 s48, s4, 15
  s_lshl_b32 s48, s48, 12
  s_add_u32 s48, s48, 720896
  s_waitcnt lgkmcnt(0)
  buffer_store_dwordx4 v[88:91], v92, s[12:15], s59 offen sc1
  s_mov_b64 exec, -1
  s_cmp_lg_u32 s3, s98
  s_cbranch_scc1 L_a_fin
  s_sleep 12
  s_mov_b32 s56, 0
  s_mov_b32 s45, s48
L_red_ld:
  buffer_load_dwordx4 v[64:67], v8, s[12:15], s45 offen offset:0 sc1
  buffer_load_dwordx4 v[68:71], v8, s[12:15], s45 offen offset:1024 sc1
  buffer_load_dwordx4 v[72:75], v8, s[12:15], s45 offen offset:2048 sc1
  buffer_load_dwordx4 v[76:79], v8, s[12:15], s45 offen offset:3072 sc1
  s_add_u32 s56, s56, 1
  s_mov_b32 s45, s48
  s_waitcnt vmcnt(0)
L_red_chk:
  v_xor_b32 v80, s44, v67
  v_xor_b32 v81, s44, v71
  v_xor_b32 v82, s44, v75
  v_xor_b32 v83, s44, v79
  v_or3_b32 v80, v80, v81, v82
  v_or_b32 v80, v80, v83
  v_cmp_ne_u32 vcc, 0, v80
  s_cbranch_vccz L_red_ok
  s_cmp_lt_u32 s56, 262144
  s_cbranch_scc1 L_red_ld
L_red_ok:
  v_perm_b32 v67, v65, v64, s53
  v_lshl_or_b32 v67, v66, 24, v67
  v_perm_b32 v71, v69, v68, s53
  v_lshl_or_b32 v71, v70, 24, v71
  v_perm_b32 v75, v73, v72, s53
  v_lshl_or_b32 v75, v74, 24, v75
  v_perm_b32 v79, v77, v76, s53
  v_lshl_or_b32 v79, v78, 24, v79
  v_add_f32 v64, v64, v68
  v_add_f32 v72, v72, v76
  v_add_f32 v65, v65, v69
  v_add_f32 v73, v73, v77
  v_add_f32 v66, v66, v70
  v_add_f32 v74, v74, v78
  v_add_f32 v67, v67, v71
  v_add_f32 v75, v75, v79
  v_add_f32 v64, v64, v72
  v_add_f32 v65, v65, v73
  v_add_f32 v66, v66, v74
  v_add_f32 v67, v67, v75
  s_nop 1
  v_permlane32_swap_b32 v64, v66
  v_permlane32_swap_b32 v65, v67
  s_nop 0
  v_add_f32 v64, v64, v66
  v_add_f32 v65, v65, v67
  s_nop 1
  v_permlane16_swap_b32 v64, v65
  s_nop 0
  v_add_f32 v64, v64, v65
  v_lshlrev_b32 v180, 16, v180
  v_add_f32 v64, v64, v180
  v_cvt_pk_bf16_f32 v64, v64, v64
  buffer_store_short v64, v49, s[40:43], s100 offen
  s_cmpk_lg_u32 s2, 128
  s_cbranch_scc1 L_a_fin
  v_mov_b32 v57, s44
  v_mov_b32 v58, 0
  s_mov_b64 exec, 1
  buffer_store_dword v57, v58, s[12:15], 0 offen sc1
L_a_fin:
L_end:
  s_endpgm
L_codeend:
.section .rodata,"a"
.p2align 6
.amdhsa_kernel parallel_sum__compressed_kv_cla__dense_activation_silu__decode_kernel
  .amdhsa_next_free_vgpr 256
  .amdhsa_next_free_sgpr 102
  .amdhsa_accum_offset 256
  .amdhsa_group_segment_fixed_size 0
  .amdhsa_kernarg_size 96
  .amdhsa_user_sgpr_count 2
  .amdhsa_user_sgpr_kernarg_segment_ptr 1
  .amdhsa_system_sgpr_workgroup_id_x 1
.end_amdhsa_kernel
```
